```python
import torch

def _softmax(x, axis=-1):
    return torch.softmax(x, dim=axis)
def _gelu(x):
    return torch.nn.functional.gelu(x, approximate="tanh")
def _silu(x):
    return torch.nn.functional.silu(x)
def _sigmoid(x):
    return torch.sigmoid(x)
def _layernorm(x, axis=-1, eps=1e-5):
    m = x.mean(dim=axis, keepdim=True)
    v = x.var(dim=axis, keepdim=True, unbiased=False)
    return (x - m) / torch.sqrt(v + eps)
def _scatter_add(tgt, idx, src, axis=0):
    return tgt.clone().index_add_(axis, idx, src)
def _segment_sum(src, seg, n):
    out = torch.zeros((n,) + src.shape[1:], dtype=src.dtype)
    return out.index_add_(0, seg, src)
def _pad(x, pw):
    flat = tuple(v for pair in reversed(pw) for v in pair)
    return torch.nn.functional.pad(x, flat)

kernel_name = 'standalone__grn__sampling'

def setup_inputs():

    _w = (lambda a: (lambda t: t.to(torch.bfloat16) if t.is_floating_point() else t)(torch.as_tensor(a)))
    B, S, D = 1024, 16, 640
    return {
        "x": _w((lambda *s: torch.randn(*s, dtype=torch.bfloat16) * 0.05)(B, S, D)),
        "g": _w((lambda *s: torch.randn(*s, dtype=torch.bfloat16) * 0.4)(D) * 0.1),
        "b": _w((lambda *s: torch.randn(*s, dtype=torch.bfloat16) * 0.1)(D) * 0.1),
    }

def reference(x, g, b):
    gx = torch.sqrt((x * x).sum(axis=-2, keepdims=True))
    nx = gx / (gx.mean(axis=-1, keepdims=True) + 1e-6)
    return g * (x * nx) + b + x
```

```asm
; @launch grid=(1024,1,1) block=(320,1,1) lds=64
.amdgcn_target "amdgcn-amd-amdhsa--gfx950"
.text
.globl standalone__grn__sampling_kernel
.p2align 8
.type standalone__grn__sampling_kernel,@function
standalone__grn__sampling_kernel:
  s_setprio 3
  s_load_dwordx4 s[4:7], s[0:1], 0
  s_load_dwordx4 s[8:11], s[0:1], 16
  s_cmp_ge_u32 s2, 1024
  s_cbranch_scc1 L_end
  s_mul_i32 s3, s2, 20480
  v_and_b32 v1, 15, v0
  v_lshrrev_b32 v2, 6, v0
  v_bfe_u32 v3, v0, 4, 2
  v_lshlrev_b32 v1, 4, v1
  v_lshl_add_u32 v1, v2, 8, v1
  v_mul_u32_u24 v4, 5120, v3
  v_add3_u32 v4, v4, v1, s3
  v_lshl_add_u32 v5, v3, 2, v1
  v_lshlrev_b32 v6, 2, v2
  v_mov_b32 v7, 0
  s_mov_b32 s12, 0xffff0000
  s_mov_b32 s14, 0
  s_mov_b32 s15, 0x80000000
  s_waitcnt lgkmcnt(0)
  s_load_dword s16, s[6:7], 0
  s_load_dword s17, s[8:9], 0
  global_load_dwordx4 v[12:15], v4, s[4:5] nt
  global_load_dwordx4 v[20:23], v4, s[4:5] offset:1280 nt
  global_load_dwordx4 v[28:31], v4, s[4:5] offset:2560 nt
  global_load_dwordx4 v[36:39], v4, s[4:5] offset:3840 nt
  global_load_dword v57, v5, s[6:7]
  global_load_dwordx4 v[52:55], v1, s[8:9]
  s_setprio 0
  s_waitcnt vmcnt(5)
  v_lshlrev_b32 v8, 16, v12
  v_and_b32 v9, s12, v12
  v_lshlrev_b32 v10, 16, v13
  v_and_b32 v11, s12, v13
  v_lshlrev_b32 v12, 16, v14
  v_and_b32 v13, s12, v14
  v_lshlrev_b32 v14, 16, v15
  v_and_b32 v15, s12, v15
  v_pk_mul_f32 v[40:41], v[8:9], v[8:9]
  v_pk_mul_f32 v[42:43], v[10:11], v[10:11]
  v_pk_mul_f32 v[44:45], v[12:13], v[12:13]
  v_pk_mul_f32 v[46:47], v[14:15], v[14:15]
  s_waitcnt vmcnt(4)
  v_lshlrev_b32 v16, 16, v20
  v_and_b32 v17, s12, v20
  v_lshlrev_b32 v18, 16, v21
  v_and_b32 v19, s12, v21
  v_lshlrev_b32 v20, 16, v22
  v_and_b32 v21, s12, v22
  v_lshlrev_b32 v22, 16, v23
  v_and_b32 v23, s12, v23
  v_pk_fma_f32 v[40:41], v[16:17], v[16:17], v[40:41]
  v_pk_fma_f32 v[42:43], v[18:19], v[18:19], v[42:43]
  v_pk_fma_f32 v[44:45], v[20:21], v[20:21], v[44:45]
  v_pk_fma_f32 v[46:47], v[22:23], v[22:23], v[46:47]
  s_waitcnt vmcnt(3)
  v_lshlrev_b32 v24, 16, v28
  v_and_b32 v25, s12, v28
  v_lshlrev_b32 v26, 16, v29
  v_and_b32 v27, s12, v29
  v_lshlrev_b32 v28, 16, v30
  v_and_b32 v29, s12, v30
  v_lshlrev_b32 v30, 16, v31
  v_and_b32 v31, s12, v31
  v_pk_fma_f32 v[40:41], v[24:25], v[24:25], v[40:41]
  v_pk_fma_f32 v[42:43], v[26:27], v[26:27], v[42:43]
  v_pk_fma_f32 v[44:45], v[28:29], v[28:29], v[44:45]
  v_pk_fma_f32 v[46:47], v[30:31], v[30:31], v[46:47]
  s_waitcnt vmcnt(2)
  v_lshlrev_b32 v32, 16, v36
  v_and_b32 v33, s12, v36
  v_lshlrev_b32 v34, 16, v37
  v_and_b32 v35, s12, v37
  v_lshlrev_b32 v36, 16, v38
  v_and_b32 v37, s12, v38
  v_lshlrev_b32 v38, 16, v39
  v_and_b32 v39, s12, v39
  v_pk_fma_f32 v[40:41], v[32:33], v[32:33], v[40:41]
  v_pk_fma_f32 v[42:43], v[34:35], v[34:35], v[42:43]
  v_pk_fma_f32 v[44:45], v[36:37], v[36:37], v[44:45]
  v_pk_fma_f32 v[46:47], v[38:39], v[38:39], v[46:47]
  s_nop 0
  v_permlane32_swap_b32 v40, v44
  v_permlane32_swap_b32 v41, v45
  v_permlane32_swap_b32 v42, v46
  v_permlane32_swap_b32 v43, v47
  v_pk_add_f32 v[40:41], v[40:41], v[44:45]
  v_pk_add_f32 v[42:43], v[42:43], v[46:47]
  s_nop 1
  v_permlane16_swap_b32 v40, v42
  v_permlane16_swap_b32 v41, v43
  v_pk_add_f32 v[40:41], v[40:41], v[42:43]
  v_sqrt_f32 v40, v40
  v_sqrt_f32 v41, v41
  s_nop 0
  v_add_f32 v58, v40, v41
  s_nop 1
  v_add_f32_dpp v58, v58, v58 quad_perm:[1,0,3,2] row_mask:0xf bank_mask:0xf
  s_nop 1
  v_add_f32_dpp v58, v58, v58 quad_perm:[2,3,0,1] row_mask:0xf bank_mask:0xf
  s_nop 1
  v_add_f32_dpp v58, v58, v58 row_half_mirror row_mask:0xf bank_mask:0xf
  s_nop 1
  v_add_f32_dpp v58, v58, v58 row_mirror row_mask:0xf bank_mask:0xf
  s_nop 1
  v_add_f32_dpp v58, v58, v58 row_bcast:15 row_mask:0xa bank_mask:0xf
  s_nop 1
  v_add_f32_dpp v58, v58, v58 row_bcast:31 row_mask:0xc bank_mask:0xf
  s_mov_b64 exec, s[14:15]
  ds_write_b32 v6, v58
  s_mov_b64 exec, -1
  s_mov_b32 s13, 0x3acccccd
  v_mov_b32 v2, 0x358637bd
  s_waitcnt lgkmcnt(0)
  s_barrier
  ds_read_b128 v[60:63], v7
  ds_read_b32 v58, v7 offset:16
  s_waitcnt vmcnt(1)
  v_lshlrev_b32 v56, 16, v57
  v_and_b32 v57, s12, v57
  v_pk_mul_f32 v[40:41], v[40:41], v[56:57]
  v_mov_b64 v[42:43], v[40:41]
  s_waitcnt vmcnt(0)
  v_lshlrev_b32 v48, 16, v52
  v_and_b32 v49, s12, v52
  v_permlane16_swap_b32 v40, v42
  v_permlane16_swap_b32 v41, v43
  v_mov_b64 v[44:45], v[40:41]
  v_mov_b64 v[46:47], v[42:43]
  v_lshlrev_b32 v50, 16, v53
  v_and_b32 v51, s12, v53
  v_permlane32_swap_b32 v40, v44
  v_permlane32_swap_b32 v41, v45
  v_permlane32_swap_b32 v42, v46
  v_permlane32_swap_b32 v43, v47
  v_lshlrev_b32 v52, 16, v54
  v_and_b32 v53, s12, v54
  v_lshlrev_b32 v54, 16, v55
  v_and_b32 v55, s12, v55
  s_waitcnt lgkmcnt(0)
  v_pk_add_f32 v[60:61], v[60:61], v[62:63]
  v_add_f32 v58, v58, v60
  v_add_f32 v58, v58, v61
  v_fma_f32 v58, v58, s13, v2
  v_rcp_f32 v58, v58
  s_nop 0
  v_pk_fma_f32 v[40:41], v[40:41], v[58:59], 1.0 op_sel_hi:[1,0,0]
  v_pk_fma_f32 v[42:43], v[42:43], v[58:59], 1.0 op_sel_hi:[1,0,0]
  v_pk_fma_f32 v[44:45], v[44:45], v[58:59], 1.0 op_sel_hi:[1,0,0]
  v_pk_fma_f32 v[46:47], v[46:47], v[58:59], 1.0 op_sel_hi:[1,0,0]
  v_pk_fma_f32 v[8:9], v[8:9], v[40:41], v[48:49]
  v_pk_fma_f32 v[10:11], v[10:11], v[42:43], v[50:51]
  v_pk_fma_f32 v[12:13], v[12:13], v[44:45], v[52:53]
  v_pk_fma_f32 v[14:15], v[14:15], v[46:47], v[54:55]
  v_cvt_pk_bf16_f32 v8, v8, v9
  v_cvt_pk_bf16_f32 v9, v10, v11
  v_cvt_pk_bf16_f32 v10, v12, v13
  v_cvt_pk_bf16_f32 v11, v14, v15
  global_store_dwordx4 v4, v[8:11], s[10:11] nt
  v_pk_fma_f32 v[16:17], v[16:17], v[40:41], v[48:49]
  v_pk_fma_f32 v[18:19], v[18:19], v[42:43], v[50:51]
  v_pk_fma_f32 v[20:21], v[20:21], v[44:45], v[52:53]
  v_pk_fma_f32 v[22:23], v[22:23], v[46:47], v[54:55]
  v_cvt_pk_bf16_f32 v16, v16, v17
  v_cvt_pk_bf16_f32 v17, v18, v19
  v_cvt_pk_bf16_f32 v18, v20, v21
  v_cvt_pk_bf16_f32 v19, v22, v23
  global_store_dwordx4 v4, v[16:19], s[10:11] offset:1280 nt
  v_pk_fma_f32 v[24:25], v[24:25], v[40:41], v[48:49]
  v_pk_fma_f32 v[26:27], v[26:27], v[42:43], v[50:51]
  v_pk_fma_f32 v[28:29], v[28:29], v[44:45], v[52:53]
  v_pk_fma_f32 v[30:31], v[30:31], v[46:47], v[54:55]
  v_cvt_pk_bf16_f32 v24, v24, v25
  v_cvt_pk_bf16_f32 v25, v26, v27
  v_cvt_pk_bf16_f32 v26, v28, v29
  v_cvt_pk_bf16_f32 v27, v30, v31
  global_store_dwordx4 v4, v[24:27], s[10:11] offset:2560 nt
  v_pk_fma_f32 v[32:33], v[32:33], v[40:41], v[48:49]
  v_pk_fma_f32 v[34:35], v[34:35], v[42:43], v[50:51]
  v_pk_fma_f32 v[36:37], v[36:37], v[44:45], v[52:53]
  v_pk_fma_f32 v[38:39], v[38:39], v[46:47], v[54:55]
  v_cvt_pk_bf16_f32 v32, v32, v33
  v_cvt_pk_bf16_f32 v33, v34, v35
  v_cvt_pk_bf16_f32 v34, v36, v37
  v_cvt_pk_bf16_f32 v35, v38, v39
  global_store_dwordx4 v4, v[32:35], s[10:11] offset:3840 nt
L_end:
  s_endpgm
.section .rodata,"a"
.p2align 6
.amdhsa_kernel standalone__grn__sampling_kernel
  .amdhsa_next_free_vgpr 64
  .amdhsa_next_free_sgpr 24
  .amdhsa_accum_offset 64
  .amdhsa_group_segment_fixed_size 0
  .amdhsa_kernarg_size 48
  .amdhsa_user_sgpr_count 2
  .amdhsa_user_sgpr_kernarg_segment_ptr 1
  .amdhsa_system_sgpr_workgroup_id_x 1
  .amdhsa_float_denorm_mode_32 3
.end_amdhsa_kernel
```
